```python
import torch

def _softmax(x, axis=-1):
    return torch.softmax(x, dim=axis)
def _gelu(x):
    return torch.nn.functional.gelu(x, approximate="tanh")
def _silu(x):
    return torch.nn.functional.silu(x)
def _sigmoid(x):
    return torch.sigmoid(x)
def _layernorm(x, axis=-1, eps=1e-5):
    m = x.mean(dim=axis, keepdim=True)
    v = x.var(dim=axis, keepdim=True, unbiased=False)
    return (x - m) / torch.sqrt(v + eps)
def _scatter_add(tgt, idx, src, axis=0):
    return tgt.clone().index_add_(axis, idx, src)
def _segment_sum(src, seg, n):
    out = torch.zeros((n,) + src.shape[1:], dtype=src.dtype)
    return out.index_add_(0, seg, src)
def _pad(x, pw):
    flat = tuple(v for pair in reversed(pw) for v in pair)
    return torch.nn.functional.pad(x, flat)

kernel_name = 'standalone__weight_only_int_omniquant__prompt'

def setup_inputs():

    _w = (lambda a: (lambda t: t.to(torch.bfloat16) if t.is_floating_point() else t)(torch.as_tensor(a)))
    B, S, D, F = 1, 2048, 1024, 3584
    bits = 8
    G = 32 if 32 > 0 else D
    D = (D // G) * G
    ng = D // G
    qmax = (1 << bits) - 1
    qw = torch.randint(0, qmax + 1, (D, F)).to(torch.int32)
    scales = (torch.abs((lambda *s: torch.randn(*s, dtype=torch.bfloat16) * 0.05)(ng, F)) * 0.05 + 0.01).to(float)
    zeros = torch.randint(0, qmax + 1, (ng, F)).to(float)
    act_scale = (torch.abs((lambda *s: torch.randn(*s, dtype=torch.bfloat16) * 0.05)(D)) * 0.5 + 0.5).to(float)
    return {
        "x": _w((lambda *s: torch.randn(*s, dtype=torch.bfloat16) * 0.05)(B, S, D)),
        "qw": _w(qw),
        "scales": _w(scales),
        "zeros": _w(zeros),
        "act_scale": _w(act_scale),
    }

def reference(x, qw, scales, zeros, act_scale):
    B, S, D = x.shape
    ng, F = scales.shape
    G = D // ng
    s = (lambda x, n, axis: torch.repeat_interleave(x, n, dim=axis))(scales, G, axis=0)
    z = (lambda x, n, axis: torch.repeat_interleave(x, n, dim=axis))(zeros, G, axis=0)
    w = ((lambda x, dt: x.to(dt))(qw, x.dtype) - z) * s
    xs = x * (lambda x, dt: x.to(dt))(act_scale, x.dtype)
    return torch.einsum("bsd,df->bsf", xs, w)
```

```asm
; @launch grid=(256,1,1) block=(512,1,1) lds=147520
.amdgcn_target "amdgcn-amd-amdhsa--gfx950"
.text
.globl standalone__weight_only_int_omniquant__prompt_kernel
.p2align 8
.type standalone__weight_only_int_omniquant__prompt_kernel,@function
standalone__weight_only_int_omniquant__prompt_kernel:
    s_cmp_ge_u32 s2, 256
    s_cbranch_scc1 L_end
    s_load_dwordx4 s[4:7], s[0:1], 0
    s_load_dwordx4 s[8:11], s[0:1], 16
    s_load_dwordx4 s[12:15], s[0:1], 32
    s_load_dwordx2 s[42:43], s[0:1], 56
    v_lshrrev_b32 v1, 6, v0
    v_and_b32 v2, 63, v0
    s_and_b32 s54, s2, 7
    v_readfirstlane_b32 s44, v1
    s_lshr_b32 s63, s2, 3
    v_and_b32 v3, 31, v2
    v_lshrrev_b32 v4, 5, v2
    s_and_b32 s66, s44, 3
    s_cmp_ge_u32 s63, 28
    s_cbranch_scc1 L_help
    s_and_b32 s45, s54, 1
    s_lshl_b32 s45, s45, 2
    s_and_b32 s55, s63, 3
    s_add_u32 s45, s45, s55
    s_lshr_b32 s46, s54, 1
    s_mul_i32 s46, s46, 7
    s_lshr_b32 s55, s63, 2
    s_add_u32 s46, s46, s55
    s_and_b32 s74, s46, 1
    s_lshl_b32 s75, s74, 1
    s_sub_u32 s75, 2, s75
    s_lshl_b32 s75, s75, 4
    s_lshr_b32 s47, s46, 1
    s_lshl_b32 s47, s47, 2
    s_add_u32 s74, s74, s47
    s_lshl_b32 s74, s74, 4
    v_lshrrev_b32 v14, 4, v3
    v_mul_u32_u24 v14, s75, v14
    v_add3_u32 v14, v14, v3, s74
    s_lshl_b32 s55, s45, 2
    s_add_u32 s55, s55, s66
    s_mul_i32 s47, s55, 229376
    v_mul_u32_u24 v5, 114688, v4
    v_lshl_add_u32 v5, v14, 4, v5
    v_add_u32 v5, s47, v5
    s_lshr_b32 s47, s55, 1
    s_mul_i32 s47, s47, 7168
    v_lshlrev_b32 v6, 3, v14
    v_add_u32 v6, s47, v6
    s_lshl_b32 s47, s55, 5
    v_lshlrev_b32 v7, 4, v4
    v_add_u32 v7, s47, v7
    s_cmp_lt_u32 s44, 4
    s_cbranch_scc1 L_cons
    s_waitcnt lgkmcnt(0)
    s_mov_b32 s20, s6
    s_mov_b32 s21, s7
    s_mov_b32 s22, 14680064
    s_mov_b32 s23, 0x00020000
    s_mov_b32 s47, 0
    buffer_load_dwordx4 v[128:131], v5, s[20:23], s47 offen nt
    s_mov_b32 s47, 14336
    buffer_load_dwordx4 v[132:135], v5, s[20:23], s47 offen nt
    s_mov_b32 s24, s8
    s_mov_b32 s25, s9
    s_mov_b32 s26, 229376
    s_mov_b32 s27, 0x00020000
    s_mov_b32 s28, s10
    s_mov_b32 s29, s11
    s_mov_b32 s30, 229376
    s_mov_b32 s31, 0x00020000
    s_mov_b32 s32, s12
    s_mov_b32 s33, s13
    s_mov_b32 s34, 2048
    s_mov_b32 s35, 0x00020000
    s_mov_b32 s47, 0
    buffer_load_dwordx2 v[160:161], v6, s[24:27], s47 offen
    buffer_load_dwordx2 v[162:163], v6, s[28:31], s47 offen
    buffer_load_dwordx4 v[164:167], v7, s[32:35], 0 offen offset:0
    s_mov_b32 s47, 28672
    buffer_load_dwordx4 v[136:139], v5, s[20:23], s47 offen nt
    s_mov_b32 s47, 43008
    buffer_load_dwordx4 v[140:143], v5, s[20:23], s47 offen nt
    s_mov_b32 s47, 57344
    buffer_load_dwordx4 v[144:147], v5, s[20:23], s47 offen nt
    s_mov_b32 s47, 71680
    buffer_load_dwordx4 v[148:151], v5, s[20:23], s47 offen nt
    s_mov_b32 s47, 86016
    buffer_load_dwordx4 v[152:155], v5, s[20:23], s47 offen nt
    s_mov_b32 s47, 100352
    buffer_load_dwordx4 v[156:159], v5, s[20:23], s47 offen nt
    s_barrier
    s_sub_u32 s55, s44, 5
    s_lshl_b32 s55, s55, 1
    s_and_b32 s55, s55, 2
    s_add_u32 s68, s42, 0
    s_addc_u32 s69, s43, 0
    s_mov_b32 s70, 7347200
    s_mov_b32 s71, 0x00020000
    s_lshl_b32 s47, s46, 7
    s_add_u32 s47, s47, 7340032
    s_add_u32 s82, s68, s47
    s_addc_u32 s83, s69, 0
    s_load_dwordx16 s[84:99], s[82:83], 0
    v_and_b32 v29, 15, v2
    v_lshlrev_b32 v29, 2, v29
    v_add_u32 v29, s47, v29
    v_add_u32 v113, 3584, v29
    s_lshl_b32 s47, s46, 4
    s_add_u32 s47, s47, s45
    s_lshl_b32 s80, s47, 14
    v_lshlrev_b32 v25, 4, v2
    s_mov_b32 s16, s4
    s_mov_b32 s17, s5
    s_mov_b32 s18, 4194304
    s_mov_b32 s19, 0x00020000
    s_lshl_b32 s47, s55, 6
    s_lshl_b32 s48, s45, 8
    s_add_u32 s47, s47, s48
    s_lshl_b32 s47, s47, 11
    v_lshrrev_b32 v11, 3, v2
    v_lshlrev_b32 v11, 11, v11
    v_add_u32 v11, s47, v11
    v_and_b32 v12, 7, v2
    v_lshrrev_b32 v13, 4, v2
    v_xor_b32 v12, v12, v13
    v_xor_b32 v13, 4, v12
    v_lshl_add_u32 v12, v12, 4, v11
    v_lshl_add_u32 v13, v13, 4, v11
    v_add_u32 v16, 0, v12
    v_add_u32 v17, 15360, v13
    v_add_u32 v18, 30720, v12
    v_add_u32 v19, 46080, v13
    v_add_u32 v20, 65536, v12
    v_add_u32 v21, 80896, v13
    v_add_u32 v22, 96256, v12
    v_add_u32 v23, 111616, v13
    s_lshl_b32 s53, s55, 13
    s_lshl_b32 s47, s46, 18
    v_add_u32 v24, s47, v25
    s_lshl_b32 s47, s66, 12
    v_lshlrev_b32 v8, 11, v4
    v_add_u32 v8, s47, v8
    v_and_b32 v9, 1, v3
    v_lshl_add_u32 v8, v9, 10, v8
    v_lshlrev_b32 v9, 2, v9
    v_lshrrev_b32 v10, 1, v3
    v_xor_b32 v10, v10, v9
    v_lshl_add_u32 v8, v10, 4, v8
    s_waitcnt lgkmcnt(0)
    v_mov_b32 v114, 0
    v_writelane_b32 v114, s84, 0
    v_writelane_b32 v114, s85, 1
    v_writelane_b32 v114, s86, 2
    v_writelane_b32 v114, s87, 3
    v_writelane_b32 v114, s88, 4
    v_writelane_b32 v114, s89, 5
    v_writelane_b32 v114, s90, 6
    v_writelane_b32 v114, s91, 7
    v_writelane_b32 v114, s92, 8
    v_writelane_b32 v114, s93, 9
    v_writelane_b32 v114, s94, 10
    v_writelane_b32 v114, s95, 11
    v_writelane_b32 v114, s96, 12
    v_writelane_b32 v114, s97, 13
    v_writelane_b32 v114, s98, 14
    v_writelane_b32 v114, s99, 15
    v_add_u32 v114, 0x9e3779b1, v114
    v_mov_b32 v115, 147456
    v_mov_b32 v116, 1
    s_waitcnt vmcnt(6)
    v_lshlrev_b32 v168, 16, v160
    v_and_b32 v169, 0xffff0000, v160
    v_lshlrev_b32 v170, 16, v161
    v_and_b32 v171, 0xffff0000, v161
    v_lshlrev_b32 v172, 16, v162
    v_and_b32 v173, 0xffff0000, v162
    v_lshlrev_b32 v174, 16, v163
    v_and_b32 v175, 0xffff0000, v163
    v_lshlrev_b32 v176, 16, v164
    v_and_b32 v177, 0xffff0000, v164
    v_lshlrev_b32 v178, 16, v165
    v_and_b32 v179, 0xffff0000, v165
    v_lshlrev_b32 v180, 16, v166
    v_and_b32 v181, 0xffff0000, v166
    v_lshlrev_b32 v182, 16, v167
    v_and_b32 v183, 0xffff0000, v167
    v_mul_f32 v172, -v172, v168
    v_mul_f32 v173, -v173, v169
    v_mul_f32 v174, -v174, v170
    v_mul_f32 v175, -v175, v171
    v_cvt_f32_i32 v128, v128
    v_cvt_f32_i32 v129, v129
    v_cvt_f32_i32 v130, v130
    v_cvt_f32_i32 v131, v131
    v_fma_f32 v128, v128, v168, v172
    v_fma_f32 v129, v129, v169, v173
    v_fma_f32 v130, v130, v170, v174
    v_fma_f32 v131, v131, v171, v175
    v_mul_f32 v128, v128, v176
    v_mul_f32 v129, v129, v176
    v_mul_f32 v130, v130, v176
    v_mul_f32 v131, v131, v176
    v_cvt_f32_i32 v132, v132
    v_cvt_f32_i32 v133, v133
    v_cvt_f32_i32 v134, v134
    v_cvt_f32_i32 v135, v135
    v_fma_f32 v132, v132, v168, v172
    v_fma_f32 v133, v133, v169, v173
    v_fma_f32 v134, v134, v170, v174
    v_fma_f32 v135, v135, v171, v175
    v_mul_f32 v132, v132, v177
    v_mul_f32 v133, v133, v177
    v_mul_f32 v134, v134, v177
    v_mul_f32 v135, v135, v177
    v_cvt_pk_bf16_f32 v32, v128, v132
    v_cvt_pk_bf16_f32 v36, v129, v133
    v_cvt_pk_bf16_f32 v40, v130, v134
    v_cvt_pk_bf16_f32 v44, v131, v135
    s_waitcnt vmcnt(5)
    v_cvt_f32_i32 v136, v136
    v_cvt_f32_i32 v137, v137
    v_cvt_f32_i32 v138, v138
    v_cvt_f32_i32 v139, v139
    v_fma_f32 v136, v136, v168, v172
    v_fma_f32 v137, v137, v169, v173
    v_fma_f32 v138, v138, v170, v174
    v_fma_f32 v139, v139, v171, v175
    v_mul_f32 v136, v136, v178
    v_mul_f32 v137, v137, v178
    v_mul_f32 v138, v138, v178
    v_mul_f32 v139, v139, v178
    s_waitcnt vmcnt(4)
    v_cvt_f32_i32 v140, v140
    v_cvt_f32_i32 v141, v141
    v_cvt_f32_i32 v142, v142
    v_cvt_f32_i32 v143, v143
    v_fma_f32 v140, v140, v168, v172
    v_fma_f32 v141, v141, v169, v173
    v_fma_f32 v142, v142, v170, v174
    v_fma_f32 v143, v143, v171, v175
    v_mul_f32 v140, v140, v179
    v_mul_f32 v141, v141, v179
    v_mul_f32 v142, v142, v179
    v_mul_f32 v143, v143, v179
    v_cvt_pk_bf16_f32 v33, v136, v140
    v_cvt_pk_bf16_f32 v37, v137, v141
    v_cvt_pk_bf16_f32 v41, v138, v142
    v_cvt_pk_bf16_f32 v45, v139, v143
    s_waitcnt vmcnt(3)
    v_cvt_f32_i32 v144, v144
    v_cvt_f32_i32 v145, v145
    v_cvt_f32_i32 v146, v146
    v_cvt_f32_i32 v147, v147
    v_fma_f32 v144, v144, v168, v172
    v_fma_f32 v145, v145, v169, v173
    v_fma_f32 v146, v146, v170, v174
    v_fma_f32 v147, v147, v171, v175
    v_mul_f32 v144, v144, v180
    v_mul_f32 v145, v145, v180
    v_mul_f32 v146, v146, v180
    v_mul_f32 v147, v147, v180
    s_waitcnt vmcnt(2)
    v_cvt_f32_i32 v148, v148
    v_cvt_f32_i32 v149, v149
    v_cvt_f32_i32 v150, v150
    v_cvt_f32_i32 v151, v151
    v_fma_f32 v148, v148, v168, v172
    v_fma_f32 v149, v149, v169, v173
    v_fma_f32 v150, v150, v170, v174
    v_fma_f32 v151, v151, v171, v175
    v_mul_f32 v148, v148, v181
    v_mul_f32 v149, v149, v181
    v_mul_f32 v150, v150, v181
    v_mul_f32 v151, v151, v181
    v_cvt_pk_bf16_f32 v34, v144, v148
    v_cvt_pk_bf16_f32 v38, v145, v149
    v_cvt_pk_bf16_f32 v42, v146, v150
    v_cvt_pk_bf16_f32 v46, v147, v151
    s_waitcnt vmcnt(1)
    v_cvt_f32_i32 v152, v152
    v_cvt_f32_i32 v153, v153
    v_cvt_f32_i32 v154, v154
    v_cvt_f32_i32 v155, v155
    v_fma_f32 v152, v152, v168, v172
    v_fma_f32 v153, v153, v169, v173
    v_fma_f32 v154, v154, v170, v174
    v_fma_f32 v155, v155, v171, v175
    v_mul_f32 v152, v152, v182
    v_mul_f32 v153, v153, v182
    v_mul_f32 v154, v154, v182
    v_mul_f32 v155, v155, v182
    s_waitcnt vmcnt(0)
    v_cvt_f32_i32 v156, v156
    v_cvt_f32_i32 v157, v157
    v_cvt_f32_i32 v158, v158
    v_cvt_f32_i32 v159, v159
    v_fma_f32 v156, v156, v168, v172
    v_fma_f32 v157, v157, v169, v173
    v_fma_f32 v158, v158, v170, v174
    v_fma_f32 v159, v159, v171, v175
    v_mul_f32 v156, v156, v183
    v_mul_f32 v157, v157, v183
    v_mul_f32 v158, v158, v183
    v_mul_f32 v159, v159, v183
    v_cvt_pk_bf16_f32 v35, v152, v156
    v_cvt_pk_bf16_f32 v39, v153, v157
    v_cvt_pk_bf16_f32 v43, v154, v158
    v_cvt_pk_bf16_f32 v47, v155, v159
    buffer_store_dwordx4 v[32:35], v8, s[68:71], s80 offen offset:0 sc1
    buffer_store_dwordx4 v[36:39], v8, s[68:71], s80 offen offset:256 sc1
    buffer_store_dwordx4 v[40:43], v8, s[68:71], s80 offen offset:512 sc1
    buffer_store_dwordx4 v[44:47], v8, s[68:71], s80 offen offset:768 sc1
    ds_write_b128 v8, v[32:35] offset:32768
    ds_write_b128 v8, v[36:39] offset:33024
    ds_write_b128 v8, v[40:43] offset:33280
    ds_write_b128 v8, v[44:47] offset:33536
    s_waitcnt lgkmcnt(0)
    s_barrier
    s_waitcnt vmcnt(0)
    s_mov_b64 exec, 1
    ds_add_rtn_u32 v117, v115, v116
    s_waitcnt lgkmcnt(0)
    v_readfirstlane_b32 s47, v117
    s_cmp_lg_u32 s47, 3
    s_cbranch_scc1 L_nf0
    s_lshl_b32 s48, 1, s45
    s_mov_b32 exec_lo, s48
    buffer_store_dword v114, v113, s[68:71], 0 offen sc1
L_nf0:
    s_mov_b64 exec, -1
    s_barrier
    s_mov_b32 s52, 49152
    s_mov_b32 s49, 2
    s_cmp_eq_u32 s44, 4
    s_cbranch_scc1 L_bload
    s_cmp_eq_u32 s44, 7
    s_cbranch_scc1 L_copy
    s_lshl_b32 s51, s45, 7
    s_add_u32 s51, s51, 1024
    s_add_u32 m0, s52, s53
    s_nop 0
    buffer_load_dwordx4 v16, s[16:19], s51 offen offset:0 lds
    buffer_load_dwordx4 v17, s[16:19], s51 offen offset:1024 lds
    buffer_load_dwordx4 v18, s[16:19], s51 offen offset:2048 lds
    buffer_load_dwordx4 v19, s[16:19], s51 offen offset:3072 lds
    s_add_u32 m0, m0, 4096
    s_nop 0
    buffer_load_dwordx4 v20, s[16:19], s51 offen offset:0 lds
    buffer_load_dwordx4 v21, s[16:19], s51 offen offset:1024 lds
    buffer_load_dwordx4 v22, s[16:19], s51 offen offset:2048 lds
    buffer_load_dwordx4 v23, s[16:19], s51 offen offset:3072 lds
    s_add_u32 m0, m0, 4096
    s_add_u32 s51, s51, 131072
    buffer_load_dwordx4 v16, s[16:19], s51 offen offset:0 lds
    buffer_load_dwordx4 v17, s[16:19], s51 offen offset:1024 lds
    buffer_load_dwordx4 v18, s[16:19], s51 offen offset:2048 lds
    buffer_load_dwordx4 v19, s[16:19], s51 offen offset:3072 lds
    s_add_u32 m0, m0, 4096
    s_nop 0
    buffer_load_dwordx4 v20, s[16:19], s51 offen offset:0 lds
    buffer_load_dwordx4 v21, s[16:19], s51 offen offset:1024 lds
    buffer_load_dwordx4 v22, s[16:19], s51 offen offset:2048 lds
    buffer_load_dwordx4 v23, s[16:19], s51 offen offset:3072 lds
L_aloop:
    s_add_u32 s47, s49, s45
    s_add_u32 s67, s47, 7
    s_and_b32 s67, s67, 7
    s_and_b32 s47, s47, 7
    s_or_b32 s47, s47, 8
    s_cmp_ge_u32 s49, 9
    s_cselect_b32 s67, s47, s67
    s_add_u32 s52, s52, 49152
    s_cmp_ge_u32 s52, 147456
    s_cselect_b32 s52, 0, s52
    s_lshl_b32 s51, s67, 7
    s_add_u32 m0, s52, s53
    s_nop 0
    buffer_load_dwordx4 v16, s[16:19], s51 offen offset:0 lds
    buffer_load_dwordx4 v17, s[16:19], s51 offen offset:1024 lds
    buffer_load_dwordx4 v18, s[16:19], s51 offen offset:2048 lds
    buffer_load_dwordx4 v19, s[16:19], s51 offen offset:3072 lds
    s_add_u32 m0, m0, 4096
    s_nop 0
    buffer_load_dwordx4 v20, s[16:19], s51 offen offset:0 lds
    buffer_load_dwordx4 v21, s[16:19], s51 offen offset:1024 lds
    buffer_load_dwordx4 v22, s[16:19], s51 offen offset:2048 lds
    buffer_load_dwordx4 v23, s[16:19], s51 offen offset:3072 lds
    s_add_u32 m0, m0, 4096
    s_add_u32 s51, s51, 131072
    buffer_load_dwordx4 v16, s[16:19], s51 offen offset:0 lds
    buffer_load_dwordx4 v17, s[16:19], s51 offen offset:1024 lds
    buffer_load_dwordx4 v18, s[16:19], s51 offen offset:2048 lds
    buffer_load_dwordx4 v19, s[16:19], s51 offen offset:3072 lds
    s_add_u32 m0, m0, 4096
    s_nop 0
    buffer_load_dwordx4 v20, s[16:19], s51 offen offset:0 lds
    buffer_load_dwordx4 v21, s[16:19], s51 offen offset:1024 lds
    buffer_load_dwordx4 v22, s[16:19], s51 offen offset:2048 lds
    buffer_load_dwordx4 v23, s[16:19], s51 offen offset:3072 lds
    s_waitcnt vmcnt(16)
    s_barrier
    s_add_u32 s49, s49, 1
    s_cmp_lt_u32 s49, 16
    s_cbranch_scc1 L_aloop
    s_waitcnt vmcnt(0)
    s_barrier
    s_endpgm
L_copy:
    v_add_u32 v26, 81920, v25
    s_add_u32 s80, s80, 131072
    s_barrier
    ds_read_b128 v[128:131], v26 offset:0
    ds_read_b128 v[132:135], v26 offset:1024
    ds_read_b128 v[136:139], v26 offset:2048
    ds_read_b128 v[140:143], v26 offset:3072
    ds_read_b128 v[144:147], v26 offset:4096
    ds_read_b128 v[148:151], v26 offset:5120
    ds_read_b128 v[152:155], v26 offset:6144
    ds_read_b128 v[156:159], v26 offset:7168
    ds_read_b128 v[160:163], v26 offset:8192
    ds_read_b128 v[164:167], v26 offset:9216
    ds_read_b128 v[168:171], v26 offset:10240
    ds_read_b128 v[172:175], v26 offset:11264
    ds_read_b128 v[176:179], v26 offset:12288
    ds_read_b128 v[180:183], v26 offset:13312
    ds_read_b128 v[184:187], v26 offset:14336
    ds_read_b128 v[188:191], v26 offset:15360
    s_waitcnt lgkmcnt(0)
    s_barrier
    buffer_store_dwordx4 v[128:131], v25, s[68:71], s80 offen offset:0 sc1
    buffer_store_dwordx4 v[132:135], v25, s[68:71], s80 offen offset:1024 sc1
    buffer_store_dwordx4 v[136:139], v25, s[68:71], s80 offen offset:2048 sc1
    buffer_store_dwordx4 v[140:143], v25, s[68:71], s80 offen offset:3072 sc1
    s_add_u32 s80, s80, 4096
    buffer_store_dwordx4 v[144:147], v25, s[68:71], s80 offen offset:0 sc1
    buffer_store_dwordx4 v[148:151], v25, s[68:71], s80 offen offset:1024 sc1
    buffer_store_dwordx4 v[152:155], v25, s[68:71], s80 offen offset:2048 sc1
    buffer_store_dwordx4 v[156:159], v25, s[68:71], s80 offen offset:3072 sc1
    s_add_u32 s80, s80, 4096
    s_barrier
    buffer_store_dwordx4 v[160:163], v25, s[68:71], s80 offen offset:0 sc1
    buffer_store_dwordx4 v[164:167], v25, s[68:71], s80 offen offset:1024 sc1
    buffer_store_dwordx4 v[168:171], v25, s[68:71], s80 offen offset:2048 sc1
    buffer_store_dwordx4 v[172:175], v25, s[68:71], s80 offen offset:3072 sc1
    s_add_u32 s80, s80, 4096
    buffer_store_dwordx4 v[176:179], v25, s[68:71], s80 offen offset:0 sc1
    buffer_store_dwordx4 v[180:183], v25, s[68:71], s80 offen offset:1024 sc1
    buffer_store_dwordx4 v[184:187], v25, s[68:71], s80 offen offset:2048 sc1
    buffer_store_dwordx4 v[188:191], v25, s[68:71], s80 offen offset:3072 sc1
    s_add_u32 s80, s80, 4096
    s_barrier
    s_waitcnt vmcnt(0)
    s_lshl_b32 s48, 256, s45
    s_mov_b32 exec_lo, s48
    s_mov_b32 exec_hi, 0
    buffer_store_dword v114, v113, s[68:71], 0 offen sc1
    s_mov_b64 exec, -1
    s_endpgm
L_bload:
    s_mov_b32 s76, 0
    s_mov_b32 s78, 0
    s_mov_b32 s77, 0
L_sm:
    s_mov_b32 s79, 0
    s_cmp_ge_u32 s49, 16
    s_cbranch_scc1 L_trybar
    s_add_u32 s47, s49, s45
    s_add_u32 s67, s47, 7
    s_and_b32 s67, s67, 7
    s_and_b32 s47, s47, 7
    s_or_b32 s47, s47, 8
    s_cmp_ge_u32 s49, 9
    s_cselect_b32 s67, s47, s67
    s_bitcmp1_b32 s78, s67
    s_cbranch_scc0 L_dopoll
    s_add_u32 s47, s76, 2
    s_cmp_gt_u32 s49, s47
    s_cbranch_scc1 L_trybar
    s_add_u32 s52, s52, 49152
    s_cmp_ge_u32 s52, 147456
    s_cselect_b32 s52, 0, s52
    s_lshl_b32 s50, s67, 14
    s_add_u32 m0, s52, 32768
    s_nop 0
    buffer_load_dwordx4 v24, s[68:71], s50 offen offset:0 sc1 lds
    buffer_load_dwordx4 v24, s[68:71], s50 offen offset:1024 sc1 lds
    buffer_load_dwordx4 v24, s[68:71], s50 offen offset:2048 sc1 lds
    buffer_load_dwordx4 v24, s[68:71], s50 offen offset:3072 sc1 lds
    s_add_u32 m0, s52, 36864
    s_add_u32 s50, s50, 4096
    buffer_load_dwordx4 v24, s[68:71], s50 offen offset:0 sc1 lds
    buffer_load_dwordx4 v24, s[68:71], s50 offen offset:1024 sc1 lds
    buffer_load_dwordx4 v24, s[68:71], s50 offen offset:2048 sc1 lds
    buffer_load_dwordx4 v24, s[68:71], s50 offen offset:3072 sc1 lds
    s_add_u32 m0, s52, 40960
    s_add_u32 s50, s50, 4096
    buffer_load_dwordx4 v24, s[68:71], s50 offen offset:0 sc1 lds
    buffer_load_dwordx4 v24, s[68:71], s50 offen offset:1024 sc1 lds
    buffer_load_dwordx4 v24, s[68:71], s50 offen offset:2048 sc1 lds
    buffer_load_dwordx4 v24, s[68:71], s50 offen offset:3072 sc1 lds
    s_add_u32 m0, s52, 45056
    s_add_u32 s50, s50, 4096
    buffer_load_dwordx4 v24, s[68:71], s50 offen offset:0 sc1 lds
    buffer_load_dwordx4 v24, s[68:71], s50 offen offset:1024 sc1 lds
    buffer_load_dwordx4 v24, s[68:71], s50 offen offset:2048 sc1 lds
    buffer_load_dwordx4 v24, s[68:71], s50 offen offset:3072 sc1 lds
    s_add_u32 s49, s49, 1
    s_branch L_sm
L_dopoll:
    s_mov_b64 exec, 0xffff
    buffer_load_dword v28, v113, s[68:71], 0 offen sc1
    s_add_u32 s77, s77, 1
    s_mov_b32 s79, 1
    s_cmp_le_u32 s77, 1
    s_cbranch_scc1 L_nobar
L_trybar:
    s_sub_u32 s47, s49, s76
    s_cmp_le_u32 s47, 1
    s_cbranch_scc1 L_nobar
    s_lshl_b32 s47, s47, 1
    s_add_u32 s47, s47, s79
    s_cmp_eq_u32 s47, 6
    s_cbranch_scc1 L_w16
    s_cmp_eq_u32 s47, 7
    s_cbranch_scc1 L_w17
    s_cmp_eq_u32 s47, 5
    s_cbranch_scc1 L_w1
    s_waitcnt vmcnt(0)
L_w1:
    s_waitcnt vmcnt(1)
L_w16:
    s_waitcnt vmcnt(16)
L_w17:
    s_waitcnt vmcnt(17)
    s_barrier
    s_add_u32 s76, s76, 1
    s_cmp_ge_u32 s76, 15
    s_cbranch_scc1 L_bdone
L_nobar:
    s_cmp_eq_u32 s79, 0
    s_cbranch_scc1 L_sm
    s_cmp_lt_u32 s77, 0x40000
    s_cbranch_scc1 L_waitpoll
    s_mov_b32 s78, 0xffff
L_waitpoll:
    s_waitcnt vmcnt(0)
L_gotpoll:
    v_cmp_eq_u32 vcc, v28, v114
    s_or_b32 s78, s78, vcc_lo
    s_mov_b64 exec, -1
    s_branch L_sm
L_bdone:
    s_lshl_b32 s48, 0x101, s45
    s_mov_b32 exec_lo, s48
    s_mov_b32 exec_hi, 0
    buffer_store_dword v114, v29, s[68:71], 0 offen sc1
    s_mov_b64 exec, -1
    s_endpgm
L_cons:
    v_mov_b32 v14, 0
    v_mov_b32 v115, 147456
    ds_write_b32 v115, v14
    v_mov_b32 v100, v5
    v_mov_b32 v101, v6
    v_mov_b32 v102, v7
    s_lshl_b32 s47, s66, 12
    v_lshlrev_b32 v8, 11, v4
    v_add_u32 v8, s47, v8
    v_and_b32 v9, 1, v3
    v_lshl_add_u32 v8, v9, 10, v8
    v_lshlrev_b32 v9, 2, v9
    v_lshrrev_b32 v10, 1, v3
    v_xor_b32 v10, v10, v9
    v_lshl_add_u32 v8, v10, 4, v8
    v_add_u32 v103, 49152, v8
    s_lshl_b32 s47, s66, 6
    s_lshl_b32 s48, s45, 8
    s_add_u32 s47, s47, s48
    s_lshl_b32 s47, s47, 11
    v_lshrrev_b32 v11, 3, v2
    v_lshlrev_b32 v11, 11, v11
    v_add_u32 v11, s47, v11
    v_and_b32 v12, 7, v2
    v_lshrrev_b32 v13, 4, v2
    v_xor_b32 v12, v12, v13
    v_xor_b32 v13, 4, v12
    v_lshl_add_u32 v12, v12, 4, v11
    v_lshl_add_u32 v13, v13, 4, v11
    v_add_u32 v16, 0, v12
    v_add_u32 v17, 15360, v13
    v_add_u32 v18, 30720, v12
    v_add_u32 v19, 46080, v13
    v_add_u32 v20, 65536, v12
    v_add_u32 v21, 80896, v13
    v_add_u32 v22, 96256, v12
    v_add_u32 v23, 111616, v13
    s_lshl_b32 s53, s66, 13
    s_waitcnt lgkmcnt(0)
    s_mov_b32 s16, s4
    s_mov_b32 s17, s5
    s_mov_b32 s18, 4194304
    s_mov_b32 s19, 0x00020000
    s_mov_b32 s20, s6
    s_mov_b32 s21, s7
    s_mov_b32 s22, 14680064
    s_mov_b32 s23, 0x00020000
    s_mov_b32 s24, s8
    s_mov_b32 s25, s9
    s_mov_b32 s26, 229376
    s_mov_b32 s27, 0x00020000
    s_mov_b32 s28, s10
    s_mov_b32 s29, s11
    s_mov_b32 s30, 229376
    s_mov_b32 s31, 0x00020000
    s_mov_b32 s32, s12
    s_mov_b32 s33, s13
    s_mov_b32 s34, 2048
    s_mov_b32 s35, 0x00020000
    s_mov_b32 s52, 0
    s_lshl_b32 s51, s45, 7
    s_barrier
    s_mov_b32 s47, 7340032
    buffer_load_dwordx4 v[56:59], v100, s[20:23], s47 offen nt
    s_mov_b32 s47, 7354368
    buffer_load_dwordx4 v[60:63], v100, s[20:23], s47 offen nt
    s_add_u32 m0, s52, s53
    s_nop 0
    buffer_load_dwordx4 v16, s[16:19], s51 offen offset:0 lds
    buffer_load_dwordx4 v17, s[16:19], s51 offen offset:1024 lds
    buffer_load_dwordx4 v18, s[16:19], s51 offen offset:2048 lds
    buffer_load_dwordx4 v19, s[16:19], s51 offen offset:3072 lds
    s_add_u32 m0, m0, 4096
    s_nop 0
    buffer_load_dwordx4 v20, s[16:19], s51 offen offset:0 lds
    buffer_load_dwordx4 v21, s[16:19], s51 offen offset:1024 lds
    buffer_load_dwordx4 v22, s[16:19], s51 offen offset:2048 lds
    buffer_load_dwordx4 v23, s[16:19], s51 offen offset:3072 lds
    v_lshrrev_b32 v3, 4, v2
    v_and_b32 v4, 15, v2
    v_lshlrev_b32 v5, 7, v4
    v_add_u32 v5, s53, v5
    v_bfe_u32 v6, v4, 1, 3
    v_add_u32 v10, 0, v3
    v_xor_b32 v10, v10, v6
    v_lshl_add_u32 v104, v10, 4, v5
    v_add_u32 v10, 4, v3
    v_xor_b32 v10, v10, v6
    v_lshl_add_u32 v105, v10, 4, v5
    v_lshlrev_b32 v10, 11, v3
    v_add_u32 v10, 32768, v10
    v_lshl_add_u32 v106, v4, 4, v10
    v_xor_b32 v11, 4, v4
    v_lshl_add_u32 v107, v11, 4, v10
    v_mov_b32 v108, v104
    v_mov_b32 v109, v105
    v_mov_b32 v110, v106
    v_mov_b32 v111, v107
    s_lshl_b32 s47, s66, 6
    s_lshl_b32 s48, s45, 8
    s_add_u32 s47, s47, s48
    s_mul_i32 s47, s47, 7168
    s_lshl_b32 s48, s74, 3
    s_add_u32 s47, s47, s48
    v_mul_u32_u24 v10, 28672, v3
    v_lshl_add_u32 v10, v4, 4, v10
    v_lshrrev_b32 v11, 3, v4
    v_mul_u32_u24 v11, s75, v11
    v_lshl_add_u32 v10, v11, 3, v10
    v_add_u32 v112, s47, v10
    s_mov_b32 s36, s14
    s_mov_b32 s37, s15
    s_mov_b32 s38, 14680064
    s_mov_b32 s39, 0x00020000
    s_barrier
    s_mov_b32 s47, 114688
    buffer_load_dwordx2 v[88:89], v101, s[24:27], s47 offen
    buffer_load_dwordx2 v[90:91], v101, s[28:31], s47 offen
    buffer_load_dwordx4 v[92:95], v102, s[32:35], 0 offen offset:1024
    s_mov_b32 s47, 7368704
    buffer_load_dwordx4 v[64:67], v100, s[20:23], s47 offen nt
    s_mov_b32 s47, 7383040
    buffer_load_dwordx4 v[68:71], v100, s[20:23], s47 offen nt
    s_mov_b32 s47, 7397376
    buffer_load_dwordx4 v[72:75], v100, s[20:23], s47 offen nt
    s_mov_b32 s47, 7411712
    buffer_load_dwordx4 v[76:79], v100, s[20:23], s47 offen nt
    s_mov_b32 s47, 7426048
    buffer_load_dwordx4 v[80:83], v100, s[20:23], s47 offen nt
    s_mov_b32 s47, 7440384
    buffer_load_dwordx4 v[84:87], v100, s[20:23], s47 offen nt
    s_waitcnt vmcnt(9)
    ds_read_b128 v[8:11], v108 offset:0
    ds_read_b128 v[24:27], v110 offset:0
    ds_read_b128 v[28:31], v110 offset:256
    ds_read_b128 v[32:35], v110 offset:512
    ds_read_b128 v[36:39], v110 offset:768
    ds_read_b128 v[40:43], v111 offset:1024
    ds_read_b128 v[44:47], v111 offset:1280
    ds_read_b128 v[48:51], v111 offset:1536
    ds_read_b128 v[52:55], v111 offset:1792
    ds_read_b128 v[12:15], v108 offset:2048
    ds_read_b128 v[16:19], v108 offset:4096
    ds_read_b128 v[20:23], v108 offset:6144
    s_waitcnt lgkmcnt(0)
    v_mfma_f32_16x16x32_bf16 v[128:131], v[8:11], v[24:27], 0
    v_mfma_f32_16x16x32_bf16 v[132:135], v[8:11], v[28:31], 0
    v_mfma_f32_16x16x32_bf16 v[136:139], v[8:11], v[32:35], 0
    v_mfma_f32_16x16x32_bf16 v[140:143], v[8:11], v[36:39], 0
    v_mfma_f32_16x16x32_bf16 v[144:147], v[8:11], v[40:43], 0
    v_mfma_f32_16x16x32_bf16 v[148:151], v[8:11], v[44:47], 0
    v_mfma_f32_16x16x32_bf16 v[152:155], v[8:11], v[48:51], 0
    v_mfma_f32_16x16x32_bf16 v[156:159], v[8:11], v[52:55], 0
    v_mfma_f32_16x16x32_bf16 v[188:191], v[12:15], v[52:55], 0
    v_mfma_f32_16x16x32_bf16 v[184:187], v[12:15], v[48:51], 0
    v_mfma_f32_16x16x32_bf16 v[180:183], v[12:15], v[44:47], 0
    v_mfma_f32_16x16x32_bf16 v[176:179], v[12:15], v[40:43], 0
    v_mfma_f32_16x16x32_bf16 v[172:175], v[12:15], v[36:39], 0
    v_mfma_f32_16x16x32_bf16 v[168:171], v[12:15], v[32:35], 0
    v_mfma_f32_16x16x32_bf16 v[164:167], v[12:15], v[28:31], 0
    v_mfma_f32_16x16x32_bf16 v[160:163], v[12:15], v[24:27], 0
    v_mfma_f32_16x16x32_bf16 v[192:195], v[16:19], v[24:27], 0
    v_mfma_f32_16x16x32_bf16 v[196:199], v[16:19], v[28:31], 0
    v_mfma_f32_16x16x32_bf16 v[200:203], v[16:19], v[32:35], 0
    v_mfma_f32_16x16x32_bf16 v[204:207], v[16:19], v[36:39], 0
    v_mfma_f32_16x16x32_bf16 v[208:211], v[16:19], v[40:43], 0
    v_mfma_f32_16x16x32_bf16 v[212:215], v[16:19], v[44:47], 0
    v_mfma_f32_16x16x32_bf16 v[216:219], v[16:19], v[48:51], 0
    v_mfma_f32_16x16x32_bf16 v[220:223], v[16:19], v[52:55], 0
    v_mfma_f32_16x16x32_bf16 v[252:255], v[20:23], v[52:55], 0
    v_mfma_f32_16x16x32_bf16 v[248:251], v[20:23], v[48:51], 0
    v_mfma_f32_16x16x32_bf16 v[244:247], v[20:23], v[44:47], 0
    v_mfma_f32_16x16x32_bf16 v[240:243], v[20:23], v[40:43], 0
    v_mfma_f32_16x16x32_bf16 v[236:239], v[20:23], v[36:39], 0
    v_mfma_f32_16x16x32_bf16 v[232:235], v[20:23], v[32:35], 0
    v_mfma_f32_16x16x32_bf16 v[228:231], v[20:23], v[28:31], 0
    v_mfma_f32_16x16x32_bf16 v[224:227], v[20:23], v[24:27], 0
    ds_read_b128 v[8:11], v109 offset:0
    ds_read_b128 v[24:27], v110 offset:8192
    ds_read_b128 v[28:31], v110 offset:8448
    ds_read_b128 v[32:35], v110 offset:8704
    ds_read_b128 v[36:39], v110 offset:8960
    ds_read_b128 v[40:43], v111 offset:9216
    ds_read_b128 v[44:47], v111 offset:9472
    ds_read_b128 v[48:51], v111 offset:9728
    ds_read_b128 v[52:55], v111 offset:9984
    ds_read_b128 v[12:15], v109 offset:2048
    ds_read_b128 v[16:19], v109 offset:4096
    ds_read_b128 v[20:23], v109 offset:6144
    s_waitcnt lgkmcnt(0)
    v_mfma_f32_16x16x32_bf16 v[128:131], v[8:11], v[24:27], v[128:131]
    v_mfma_f32_16x16x32_bf16 v[132:135], v[8:11], v[28:31], v[132:135]
    v_mfma_f32_16x16x32_bf16 v[136:139], v[8:11], v[32:35], v[136:139]
    v_mfma_f32_16x16x32_bf16 v[140:143], v[8:11], v[36:39], v[140:143]
    v_mfma_f32_16x16x32_bf16 v[144:147], v[8:11], v[40:43], v[144:147]
    v_mfma_f32_16x16x32_bf16 v[148:151], v[8:11], v[44:47], v[148:151]
    v_mfma_f32_16x16x32_bf16 v[152:155], v[8:11], v[48:51], v[152:155]
    v_mfma_f32_16x16x32_bf16 v[156:159], v[8:11], v[52:55], v[156:159]
    v_mfma_f32_16x16x32_bf16 v[188:191], v[12:15], v[52:55], v[188:191]
    v_mfma_f32_16x16x32_bf16 v[184:187], v[12:15], v[48:51], v[184:187]
    v_mfma_f32_16x16x32_bf16 v[180:183], v[12:15], v[44:47], v[180:183]
    v_mfma_f32_16x16x32_bf16 v[176:179], v[12:15], v[40:43], v[176:179]
    v_mfma_f32_16x16x32_bf16 v[172:175], v[12:15], v[36:39], v[172:175]
    v_mfma_f32_16x16x32_bf16 v[168:171], v[12:15], v[32:35], v[168:171]
    v_mfma_f32_16x16x32_bf16 v[164:167], v[12:15], v[28:31], v[164:167]
    v_mfma_f32_16x16x32_bf16 v[160:163], v[12:15], v[24:27], v[160:163]
    v_mfma_f32_16x16x32_bf16 v[192:195], v[16:19], v[24:27], v[192:195]
    v_mfma_f32_16x16x32_bf16 v[196:199], v[16:19], v[28:31], v[196:199]
    v_mfma_f32_16x16x32_bf16 v[200:203], v[16:19], v[32:35], v[200:203]
    v_mfma_f32_16x16x32_bf16 v[204:207], v[16:19], v[36:39], v[204:207]
    v_mfma_f32_16x16x32_bf16 v[208:211], v[16:19], v[40:43], v[208:211]
    v_mfma_f32_16x16x32_bf16 v[212:215], v[16:19], v[44:47], v[212:215]
    v_mfma_f32_16x16x32_bf16 v[216:219], v[16:19], v[48:51], v[216:219]
    v_mfma_f32_16x16x32_bf16 v[220:223], v[16:19], v[52:55], v[220:223]
    v_mfma_f32_16x16x32_bf16 v[252:255], v[20:23], v[52:55], v[252:255]
    v_mfma_f32_16x16x32_bf16 v[248:251], v[20:23], v[48:51], v[248:251]
    v_mfma_f32_16x16x32_bf16 v[244:247], v[20:23], v[44:47], v[244:247]
    v_mfma_f32_16x16x32_bf16 v[240:243], v[20:23], v[40:43], v[240:243]
    v_mfma_f32_16x16x32_bf16 v[236:239], v[20:23], v[36:39], v[236:239]
    v_mfma_f32_16x16x32_bf16 v[232:235], v[20:23], v[32:35], v[232:235]
    v_mfma_f32_16x16x32_bf16 v[228:231], v[20:23], v[28:31], v[228:231]
    v_mfma_f32_16x16x32_bf16 v[224:227], v[20:23], v[24:27], v[224:227]
    s_barrier
    s_waitcnt vmcnt(6)
    v_lshlrev_b32 v8, 16, v88
    v_and_b32 v9, 0xffff0000, v88
    v_lshlrev_b32 v10, 16, v89
    v_and_b32 v11, 0xffff0000, v89
    v_lshlrev_b32 v12, 16, v90
    v_and_b32 v13, 0xffff0000, v90
    v_lshlrev_b32 v14, 16, v91
    v_and_b32 v15, 0xffff0000, v91
    v_lshlrev_b32 v16, 16, v92
    v_and_b32 v17, 0xffff0000, v92
    v_lshlrev_b32 v18, 16, v93
    v_and_b32 v19, 0xffff0000, v93
    v_lshlrev_b32 v20, 16, v94
    v_and_b32 v21, 0xffff0000, v94
    v_lshlrev_b32 v22, 16, v95
    v_and_b32 v23, 0xffff0000, v95
    v_mul_f32 v12, -v12, v8
    v_mul_f32 v13, -v13, v9
    v_mul_f32 v14, -v14, v10
    v_mul_f32 v15, -v15, v11
    v_cvt_f32_i32 v56, v56
    v_cvt_f32_i32 v57, v57
    v_cvt_f32_i32 v58, v58
    v_cvt_f32_i32 v59, v59
    v_fma_f32 v56, v56, v8, v12
    v_fma_f32 v57, v57, v9, v13
    v_fma_f32 v58, v58, v10, v14
    v_fma_f32 v59, v59, v11, v15
    v_mul_f32 v56, v56, v16
    v_mul_f32 v57, v57, v16
    v_mul_f32 v58, v58, v16
    v_mul_f32 v59, v59, v16
    v_cvt_f32_i32 v60, v60
    v_cvt_f32_i32 v61, v61
    v_cvt_f32_i32 v62, v62
    v_cvt_f32_i32 v63, v63
    v_fma_f32 v60, v60, v8, v12
    v_fma_f32 v61, v61, v9, v13
    v_fma_f32 v62, v62, v10, v14
    v_fma_f32 v63, v63, v11, v15
    v_mul_f32 v60, v60, v17
    v_mul_f32 v61, v61, v17
    v_mul_f32 v62, v62, v17
    v_mul_f32 v63, v63, v17
    v_cvt_pk_bf16_f32 v32, v56, v60
    v_cvt_pk_bf16_f32 v36, v57, v61
    v_cvt_pk_bf16_f32 v40, v58, v62
    v_cvt_pk_bf16_f32 v44, v59, v63
    s_waitcnt vmcnt(5)
    v_cvt_f32_i32 v64, v64
    v_cvt_f32_i32 v65, v65
    v_cvt_f32_i32 v66, v66
    v_cvt_f32_i32 v67, v67
    v_fma_f32 v64, v64, v8, v12
    v_fma_f32 v65, v65, v9, v13
    v_fma_f32 v66, v66, v10, v14
    v_fma_f32 v67, v67, v11, v15
    v_mul_f32 v64, v64, v18
    v_mul_f32 v65, v65, v18
    v_mul_f32 v66, v66, v18
    v_mul_f32 v67, v67, v18
    s_waitcnt vmcnt(4)
    v_cvt_f32_i32 v68, v68
    v_cvt_f32_i32 v69, v69
    v_cvt_f32_i32 v70, v70
    v_cvt_f32_i32 v71, v71
    v_fma_f32 v68, v68, v8, v12
    v_fma_f32 v69, v69, v9, v13
    v_fma_f32 v70, v70, v10, v14
    v_fma_f32 v71, v71, v11, v15
    v_mul_f32 v68, v68, v19
    v_mul_f32 v69, v69, v19
    v_mul_f32 v70, v70, v19
    v_mul_f32 v71, v71, v19
    v_cvt_pk_bf16_f32 v33, v64, v68
    v_cvt_pk_bf16_f32 v37, v65, v69
    v_cvt_pk_bf16_f32 v41, v66, v70
    v_cvt_pk_bf16_f32 v45, v67, v71
    s_waitcnt vmcnt(3)
    v_cvt_f32_i32 v72, v72
    v_cvt_f32_i32 v73, v73
    v_cvt_f32_i32 v74, v74
    v_cvt_f32_i32 v75, v75
    v_fma_f32 v72, v72, v8, v12
    v_fma_f32 v73, v73, v9, v13
    v_fma_f32 v74, v74, v10, v14
    v_fma_f32 v75, v75, v11, v15
    v_mul_f32 v72, v72, v20
    v_mul_f32 v73, v73, v20
    v_mul_f32 v74, v74, v20
    v_mul_f32 v75, v75, v20
    s_waitcnt vmcnt(2)
    v_cvt_f32_i32 v76, v76
    v_cvt_f32_i32 v77, v77
    v_cvt_f32_i32 v78, v78
    v_cvt_f32_i32 v79, v79
    v_fma_f32 v76, v76, v8, v12
    v_fma_f32 v77, v77, v9, v13
    v_fma_f32 v78, v78, v10, v14
    v_fma_f32 v79, v79, v11, v15
    v_mul_f32 v76, v76, v21
    v_mul_f32 v77, v77, v21
    v_mul_f32 v78, v78, v21
    v_mul_f32 v79, v79, v21
    v_cvt_pk_bf16_f32 v34, v72, v76
    v_cvt_pk_bf16_f32 v38, v73, v77
    v_cvt_pk_bf16_f32 v42, v74, v78
    v_cvt_pk_bf16_f32 v46, v75, v79
    s_waitcnt vmcnt(1)
    v_cvt_f32_i32 v80, v80
    v_cvt_f32_i32 v81, v81
    v_cvt_f32_i32 v82, v82
    v_cvt_f32_i32 v83, v83
    v_fma_f32 v80, v80, v8, v12
    v_fma_f32 v81, v81, v9, v13
    v_fma_f32 v82, v82, v10, v14
    v_fma_f32 v83, v83, v11, v15
    v_mul_f32 v80, v80, v22
    v_mul_f32 v81, v81, v22
    v_mul_f32 v82, v82, v22
    v_mul_f32 v83, v83, v22
    s_waitcnt vmcnt(0)
    v_cvt_f32_i32 v84, v84
    v_cvt_f32_i32 v85, v85
    v_cvt_f32_i32 v86, v86
    v_cvt_f32_i32 v87, v87
    v_fma_f32 v84, v84, v8, v12
    v_fma_f32 v85, v85, v9, v13
    v_fma_f32 v86, v86, v10, v14
    v_fma_f32 v87, v87, v11, v15
    v_mul_f32 v84, v84, v23
    v_mul_f32 v85, v85, v23
    v_mul_f32 v86, v86, v23
    v_mul_f32 v87, v87, v23
    v_cvt_pk_bf16_f32 v35, v80, v84
    v_cvt_pk_bf16_f32 v39, v81, v85
    v_cvt_pk_bf16_f32 v43, v82, v86
    v_cvt_pk_bf16_f32 v47, v83, v87
    ds_write_b128 v103, v[32:35] offset:32768
    ds_write_b128 v103, v[36:39] offset:33024
    ds_write_b128 v103, v[40:43] offset:33280
    ds_write_b128 v103, v[44:47] offset:33536
    s_setprio 1
    s_mov_b32 s49, 1
    s_mov_b32 s52, 49152
    v_add_u32 v108, s52, v104
    v_add_u32 v109, s52, v105
    v_add_u32 v110, s52, v106
    v_add_u32 v111, s52, v107
    s_waitcnt lgkmcnt(0)
    s_barrier
    ds_read_b128 v[8:11], v108 offset:0
    ds_read_b128 v[24:27], v110 offset:0
    ds_read_b128 v[28:31], v110 offset:256
    ds_read_b128 v[32:35], v110 offset:512
    ds_read_b128 v[36:39], v110 offset:768
    ds_read_b128 v[40:43], v111 offset:1024
    ds_read_b128 v[44:47], v111 offset:1280
    ds_read_b128 v[48:51], v111 offset:1536
    ds_read_b128 v[52:55], v111 offset:1792
    ds_read_b128 v[12:15], v108 offset:2048
    ds_read_b128 v[16:19], v108 offset:4096
    ds_read_b128 v[20:23], v108 offset:6144
L_cloop:
    s_waitcnt lgkmcnt(0)
    v_mfma_f32_16x16x32_bf16 v[128:131], v[8:11], v[24:27], v[128:131]
    ds_read_b128 v[56:59], v109 offset:0
    v_mfma_f32_16x16x32_bf16 v[132:135], v[8:11], v[28:31], v[132:135]
    ds_read_b128 v[72:75], v110 offset:8192
    v_mfma_f32_16x16x32_bf16 v[136:139], v[8:11], v[32:35], v[136:139]
    ds_read_b128 v[76:79], v110 offset:8448
    v_mfma_f32_16x16x32_bf16 v[140:143], v[8:11], v[36:39], v[140:143]
    ds_read_b128 v[80:83], v110 offset:8704
    v_mfma_f32_16x16x32_bf16 v[144:147], v[8:11], v[40:43], v[144:147]
    ds_read_b128 v[84:87], v110 offset:8960
    v_mfma_f32_16x16x32_bf16 v[148:151], v[8:11], v[44:47], v[148:151]
    ds_read_b128 v[88:91], v111 offset:9216
    v_mfma_f32_16x16x32_bf16 v[152:155], v[8:11], v[48:51], v[152:155]
    ds_read_b128 v[92:95], v111 offset:9472
    v_mfma_f32_16x16x32_bf16 v[156:159], v[8:11], v[52:55], v[156:159]
    ds_read_b128 v[96:99], v111 offset:9728
    v_mfma_f32_16x16x32_bf16 v[188:191], v[12:15], v[52:55], v[188:191]
    ds_read_b128 v[100:103], v111 offset:9984
    v_mfma_f32_16x16x32_bf16 v[184:187], v[12:15], v[48:51], v[184:187]
    ds_read_b128 v[60:63], v109 offset:2048
    v_mfma_f32_16x16x32_bf16 v[180:183], v[12:15], v[44:47], v[180:183]
    ds_read_b128 v[64:67], v109 offset:4096
    v_mfma_f32_16x16x32_bf16 v[176:179], v[12:15], v[40:43], v[176:179]
    ds_read_b128 v[68:71], v109 offset:6144
    v_mfma_f32_16x16x32_bf16 v[172:175], v[12:15], v[36:39], v[172:175]
    v_mfma_f32_16x16x32_bf16 v[168:171], v[12:15], v[32:35], v[168:171]
    v_mfma_f32_16x16x32_bf16 v[164:167], v[12:15], v[28:31], v[164:167]
    v_mfma_f32_16x16x32_bf16 v[160:163], v[12:15], v[24:27], v[160:163]
    v_mfma_f32_16x16x32_bf16 v[192:195], v[16:19], v[24:27], v[192:195]
    s_add_u32 s52, s52, 49152
    s_cmp_ge_u32 s52, 147456
    s_cselect_b32 s52, 0, s52
    v_mfma_f32_16x16x32_bf16 v[196:199], v[16:19], v[28:31], v[196:199]
    v_mfma_f32_16x16x32_bf16 v[200:203], v[16:19], v[32:35], v[200:203]
    s_add_u32 s49, s49, 1
    v_mfma_f32_16x16x32_bf16 v[204:207], v[16:19], v[36:39], v[204:207]
    v_mfma_f32_16x16x32_bf16 v[208:211], v[16:19], v[40:43], v[208:211]
    v_add_u32 v108, s52, v104
    v_add_u32 v109, s52, v105
    v_add_u32 v110, s52, v106
    v_add_u32 v111, s52, v107
    v_mfma_f32_16x16x32_bf16 v[212:215], v[16:19], v[44:47], v[212:215]
    v_mfma_f32_16x16x32_bf16 v[216:219], v[16:19], v[48:51], v[216:219]
    v_mfma_f32_16x16x32_bf16 v[220:223], v[16:19], v[52:55], v[220:223]
    v_mfma_f32_16x16x32_bf16 v[252:255], v[20:23], v[52:55], v[252:255]
    v_mfma_f32_16x16x32_bf16 v[248:251], v[20:23], v[48:51], v[248:251]
    v_mfma_f32_16x16x32_bf16 v[244:247], v[20:23], v[44:47], v[244:247]
    v_mfma_f32_16x16x32_bf16 v[240:243], v[20:23], v[40:43], v[240:243]
    v_mfma_f32_16x16x32_bf16 v[236:239], v[20:23], v[36:39], v[236:239]
    v_mfma_f32_16x16x32_bf16 v[232:235], v[20:23], v[32:35], v[232:235]
    v_mfma_f32_16x16x32_bf16 v[228:231], v[20:23], v[28:31], v[228:231]
    v_mfma_f32_16x16x32_bf16 v[224:227], v[20:23], v[24:27], v[224:227]
    s_waitcnt lgkmcnt(0)
    v_mfma_f32_16x16x32_bf16 v[128:131], v[56:59], v[72:75], v[128:131]
    v_mfma_f32_16x16x32_bf16 v[132:135], v[56:59], v[76:79], v[132:135]
    v_mfma_f32_16x16x32_bf16 v[136:139], v[56:59], v[80:83], v[136:139]
    v_mfma_f32_16x16x32_bf16 v[140:143], v[56:59], v[84:87], v[140:143]
    v_mfma_f32_16x16x32_bf16 v[144:147], v[56:59], v[88:91], v[144:147]
    v_mfma_f32_16x16x32_bf16 v[148:151], v[56:59], v[92:95], v[148:151]
    v_mfma_f32_16x16x32_bf16 v[152:155], v[56:59], v[96:99], v[152:155]
    v_mfma_f32_16x16x32_bf16 v[156:159], v[56:59], v[100:103], v[156:159]
    v_mfma_f32_16x16x32_bf16 v[188:191], v[60:63], v[100:103], v[188:191]
    v_mfma_f32_16x16x32_bf16 v[184:187], v[60:63], v[96:99], v[184:187]
    v_mfma_f32_16x16x32_bf16 v[180:183], v[60:63], v[92:95], v[180:183]
    v_mfma_f32_16x16x32_bf16 v[176:179], v[60:63], v[88:91], v[176:179]
    v_mfma_f32_16x16x32_bf16 v[172:175], v[60:63], v[84:87], v[172:175]
    v_mfma_f32_16x16x32_bf16 v[168:171], v[60:63], v[80:83], v[168:171]
    v_mfma_f32_16x16x32_bf16 v[164:167], v[60:63], v[76:79], v[164:167]
    s_barrier
    s_cmp_ge_u32 s49, 14
    s_cbranch_scc1 L_ctail
    v_mfma_f32_16x16x32_bf16 v[160:163], v[60:63], v[72:75], v[160:163]
    ds_read_b128 v[8:11], v108 offset:0
    v_mfma_f32_16x16x32_bf16 v[192:195], v[64:67], v[72:75], v[192:195]
    ds_read_b128 v[24:27], v110 offset:0
    v_mfma_f32_16x16x32_bf16 v[196:199], v[64:67], v[76:79], v[196:199]
    ds_read_b128 v[28:31], v110 offset:256
    v_mfma_f32_16x16x32_bf16 v[200:203], v[64:67], v[80:83], v[200:203]
    ds_read_b128 v[32:35], v110 offset:512
    v_mfma_f32_16x16x32_bf16 v[204:207], v[64:67], v[84:87], v[204:207]
    ds_read_b128 v[36:39], v110 offset:768
    v_mfma_f32_16x16x32_bf16 v[208:211], v[64:67], v[88:91], v[208:211]
    ds_read_b128 v[40:43], v111 offset:1024
    v_mfma_f32_16x16x32_bf16 v[212:215], v[64:67], v[92:95], v[212:215]
    ds_read_b128 v[44:47], v111 offset:1280
    v_mfma_f32_16x16x32_bf16 v[216:219], v[64:67], v[96:99], v[216:219]
    ds_read_b128 v[48:51], v111 offset:1536
    v_mfma_f32_16x16x32_bf16 v[220:223], v[64:67], v[100:103], v[220:223]
    ds_read_b128 v[52:55], v111 offset:1792
    v_mfma_f32_16x16x32_bf16 v[252:255], v[68:71], v[100:103], v[252:255]
    ds_read_b128 v[12:15], v108 offset:2048
    v_mfma_f32_16x16x32_bf16 v[248:251], v[68:71], v[96:99], v[248:251]
    ds_read_b128 v[16:19], v108 offset:4096
    v_mfma_f32_16x16x32_bf16 v[244:247], v[68:71], v[92:95], v[244:247]
    ds_read_b128 v[20:23], v108 offset:6144
    v_mfma_f32_16x16x32_bf16 v[240:243], v[68:71], v[88:91], v[240:243]
    v_mfma_f32_16x16x32_bf16 v[236:239], v[68:71], v[84:87], v[236:239]
    v_mfma_f32_16x16x32_bf16 v[232:235], v[68:71], v[80:83], v[232:235]
    v_mfma_f32_16x16x32_bf16 v[228:231], v[68:71], v[76:79], v[228:231]
    v_mfma_f32_16x16x32_bf16 v[224:227], v[68:71], v[72:75], v[224:227]
    s_branch L_cloop
L_ctail:
    v_mfma_f32_16x16x32_bf16 v[160:163], v[60:63], v[72:75], v[160:163]
    ds_read_b128 v[8:11], v108 offset:0
    v_mfma_f32_16x16x32_bf16 v[192:195], v[64:67], v[72:75], v[192:195]
    ds_read_b128 v[24:27], v110 offset:0
    v_mfma_f32_16x16x32_bf16 v[196:199], v[64:67], v[76:79], v[196:199]
    ds_read_b128 v[28:31], v110 offset:256
    v_mfma_f32_16x16x32_bf16 v[200:203], v[64:67], v[80:83], v[200:203]
    ds_read_b128 v[32:35], v110 offset:512
    v_mfma_f32_16x16x32_bf16 v[204:207], v[64:67], v[84:87], v[204:207]
    ds_read_b128 v[36:39], v110 offset:768
    v_mfma_f32_16x16x32_bf16 v[208:211], v[64:67], v[88:91], v[208:211]
    ds_read_b128 v[40:43], v111 offset:1024
    v_mfma_f32_16x16x32_bf16 v[212:215], v[64:67], v[92:95], v[212:215]
    ds_read_b128 v[44:47], v111 offset:1280
    v_mfma_f32_16x16x32_bf16 v[216:219], v[64:67], v[96:99], v[216:219]
    ds_read_b128 v[48:51], v111 offset:1536
    v_mfma_f32_16x16x32_bf16 v[220:223], v[64:67], v[100:103], v[220:223]
    ds_read_b128 v[52:55], v111 offset:1792
    v_mfma_f32_16x16x32_bf16 v[252:255], v[68:71], v[100:103], v[252:255]
    ds_read_b128 v[12:15], v108 offset:2048
    v_mfma_f32_16x16x32_bf16 v[248:251], v[68:71], v[96:99], v[248:251]
    v_mfma_f32_16x16x32_bf16 v[244:247], v[68:71], v[92:95], v[244:247]
    v_mfma_f32_16x16x32_bf16 v[240:243], v[68:71], v[88:91], v[240:243]
    s_add_u32 s52, s52, 49152
    s_cmp_ge_u32 s52, 147456
    s_cselect_b32 s52, 0, s52
    v_mfma_f32_16x16x32_bf16 v[236:239], v[68:71], v[84:87], v[236:239]
    v_add_u32 v116, s52, v104
    v_add_u32 v117, s52, v105
    v_add_u32 v118, s52, v106
    v_add_u32 v119, s52, v107
    v_mfma_f32_16x16x32_bf16 v[232:235], v[68:71], v[80:83], v[232:235]
    v_mfma_f32_16x16x32_bf16 v[228:231], v[68:71], v[76:79], v[228:231]
    v_mfma_f32_16x16x32_bf16 v[224:227], v[68:71], v[72:75], v[224:227]
    s_waitcnt lgkmcnt(8)
    v_mfma_f32_16x16x32_bf16 v[128:131], v[8:11], v[24:27], v[128:131]
    s_waitcnt lgkmcnt(7)
    v_mfma_f32_16x16x32_bf16 v[132:135], v[8:11], v[28:31], v[132:135]
    ds_read_b128 v[56:59], v109 offset:0
    s_waitcnt lgkmcnt(7)
    v_mfma_f32_16x16x32_bf16 v[136:139], v[8:11], v[32:35], v[136:139]
    ds_read_b128 v[72:75], v110 offset:8192
    s_waitcnt lgkmcnt(7)
    v_mfma_f32_16x16x32_bf16 v[140:143], v[8:11], v[36:39], v[140:143]
    ds_read_b128 v[76:79], v110 offset:8448
    s_waitcnt lgkmcnt(7)
    v_mfma_f32_16x16x32_bf16 v[144:147], v[8:11], v[40:43], v[144:147]
    ds_read_b128 v[80:83], v110 offset:8704
    s_waitcnt lgkmcnt(7)
    v_mfma_f32_16x16x32_bf16 v[148:151], v[8:11], v[44:47], v[148:151]
    ds_read_b128 v[84:87], v110 offset:8960
    s_waitcnt lgkmcnt(7)
    v_mfma_f32_16x16x32_bf16 v[152:155], v[8:11], v[48:51], v[152:155]
    ds_read_b128 v[88:91], v111 offset:9216
    s_waitcnt lgkmcnt(7)
    v_mfma_f32_16x16x32_bf16 v[156:159], v[8:11], v[52:55], v[156:159]
    ds_read_b128 v[92:95], v111 offset:9472
    s_waitcnt lgkmcnt(7)
    v_mfma_f32_16x16x32_bf16 v[188:191], v[12:15], v[52:55], v[188:191]
    ds_read_b128 v[96:99], v111 offset:9728
    v_mfma_f32_16x16x32_bf16 v[184:187], v[12:15], v[48:51], v[184:187]
    ds_read_b128 v[100:103], v111 offset:9984
    v_mfma_f32_16x16x32_bf16 v[180:183], v[12:15], v[44:47], v[180:183]
    ds_read_b128 v[60:63], v109 offset:2048
    v_mfma_f32_16x16x32_bf16 v[176:179], v[12:15], v[40:43], v[176:179]
    v_mfma_f32_16x16x32_bf16 v[172:175], v[12:15], v[36:39], v[172:175]
    v_mfma_f32_16x16x32_bf16 v[168:171], v[12:15], v[32:35], v[168:171]
    v_mfma_f32_16x16x32_bf16 v[164:167], v[12:15], v[28:31], v[164:167]
    v_mfma_f32_16x16x32_bf16 v[160:163], v[12:15], v[24:27], v[160:163]
    s_waitcnt lgkmcnt(8)
    v_mfma_f32_16x16x32_bf16 v[128:131], v[56:59], v[72:75], v[128:131]
    s_barrier
    s_waitcnt lgkmcnt(7)
    v_mfma_f32_16x16x32_bf16 v[132:135], v[56:59], v[76:79], v[132:135]
    ds_read_b128 v[8:11], v116 offset:0
    s_waitcnt lgkmcnt(7)
    v_mfma_f32_16x16x32_bf16 v[136:139], v[56:59], v[80:83], v[136:139]
    ds_read_b128 v[24:27], v118 offset:0
    s_waitcnt lgkmcnt(7)
    v_mfma_f32_16x16x32_bf16 v[140:143], v[56:59], v[84:87], v[140:143]
    ds_read_b128 v[28:31], v118 offset:256
    s_waitcnt lgkmcnt(7)
    v_mfma_f32_16x16x32_bf16 v[144:147], v[56:59], v[88:91], v[144:147]
    ds_read_b128 v[32:35], v118 offset:512
    s_waitcnt lgkmcnt(7)
    v_mfma_f32_16x16x32_bf16 v[148:151], v[56:59], v[92:95], v[148:151]
    ds_read_b128 v[36:39], v118 offset:768
    s_waitcnt lgkmcnt(7)
    v_mfma_f32_16x16x32_bf16 v[152:155], v[56:59], v[96:99], v[152:155]
    ds_read_b128 v[40:43], v119 offset:1024
    s_waitcnt lgkmcnt(7)
    v_mfma_f32_16x16x32_bf16 v[156:159], v[56:59], v[100:103], v[156:159]
    ds_read_b128 v[44:47], v119 offset:1280
    s_waitcnt lgkmcnt(7)
    v_mfma_f32_16x16x32_bf16 v[188:191], v[60:63], v[100:103], v[188:191]
    ds_read_b128 v[48:51], v119 offset:1536
    v_mfma_f32_16x16x32_bf16 v[184:187], v[60:63], v[96:99], v[184:187]
    ds_read_b128 v[52:55], v119 offset:1792
    v_mfma_f32_16x16x32_bf16 v[180:183], v[60:63], v[92:95], v[180:183]
    ds_read_b128 v[12:15], v116 offset:2048
    v_mfma_f32_16x16x32_bf16 v[176:179], v[60:63], v[88:91], v[176:179]
    v_mfma_f32_16x16x32_bf16 v[172:175], v[60:63], v[84:87], v[172:175]
    v_mfma_f32_16x16x32_bf16 v[168:171], v[60:63], v[80:83], v[168:171]
    v_mfma_f32_16x16x32_bf16 v[164:167], v[60:63], v[76:79], v[164:167]
    v_mfma_f32_16x16x32_bf16 v[160:163], v[60:63], v[72:75], v[160:163]
    s_waitcnt lgkmcnt(8)
    v_mfma_f32_16x16x32_bf16 v[128:131], v[8:11], v[24:27], v[128:131]
    s_waitcnt lgkmcnt(7)
    v_mfma_f32_16x16x32_bf16 v[132:135], v[8:11], v[28:31], v[132:135]
    ds_read_b128 v[56:59], v117 offset:0
    s_waitcnt lgkmcnt(7)
    v_mfma_f32_16x16x32_bf16 v[136:139], v[8:11], v[32:35], v[136:139]
    ds_read_b128 v[72:75], v118 offset:8192
    s_waitcnt lgkmcnt(7)
    v_mfma_f32_16x16x32_bf16 v[140:143], v[8:11], v[36:39], v[140:143]
    ds_read_b128 v[76:79], v118 offset:8448
    s_waitcnt lgkmcnt(7)
    v_mfma_f32_16x16x32_bf16 v[144:147], v[8:11], v[40:43], v[144:147]
    ds_read_b128 v[80:83], v118 offset:8704
    s_waitcnt lgkmcnt(7)
    v_mfma_f32_16x16x32_bf16 v[148:151], v[8:11], v[44:47], v[148:151]
    ds_read_b128 v[84:87], v118 offset:8960
    s_waitcnt lgkmcnt(7)
    v_mfma_f32_16x16x32_bf16 v[152:155], v[8:11], v[48:51], v[152:155]
    ds_read_b128 v[88:91], v119 offset:9216
    s_waitcnt lgkmcnt(7)
    v_mfma_f32_16x16x32_bf16 v[156:159], v[8:11], v[52:55], v[156:159]
    ds_read_b128 v[92:95], v119 offset:9472
    s_waitcnt lgkmcnt(7)
    v_mfma_f32_16x16x32_bf16 v[188:191], v[12:15], v[52:55], v[188:191]
    ds_read_b128 v[96:99], v119 offset:9728
    v_mfma_f32_16x16x32_bf16 v[184:187], v[12:15], v[48:51], v[184:187]
    ds_read_b128 v[100:103], v119 offset:9984
    v_mfma_f32_16x16x32_bf16 v[180:183], v[12:15], v[44:47], v[180:183]
    ds_read_b128 v[60:63], v117 offset:2048
    v_mfma_f32_16x16x32_bf16 v[176:179], v[12:15], v[40:43], v[176:179]
    v_mfma_f32_16x16x32_bf16 v[172:175], v[12:15], v[36:39], v[172:175]
    v_mfma_f32_16x16x32_bf16 v[168:171], v[12:15], v[32:35], v[168:171]
    v_mfma_f32_16x16x32_bf16 v[164:167], v[12:15], v[28:31], v[164:167]
    v_mfma_f32_16x16x32_bf16 v[160:163], v[12:15], v[24:27], v[160:163]
    s_waitcnt lgkmcnt(8)
    v_mfma_f32_16x16x32_bf16 v[128:131], v[56:59], v[72:75], v[128:131]
    s_waitcnt lgkmcnt(7)
    v_mfma_f32_16x16x32_bf16 v[132:135], v[56:59], v[76:79], v[132:135]
    ds_read_b128 v[8:11], v108 offset:4096
    s_waitcnt lgkmcnt(7)
    v_mfma_f32_16x16x32_bf16 v[136:139], v[56:59], v[80:83], v[136:139]
    ds_read_b128 v[24:27], v110 offset:0
    s_waitcnt lgkmcnt(7)
    v_mfma_f32_16x16x32_bf16 v[140:143], v[56:59], v[84:87], v[140:143]
    ds_read_b128 v[28:31], v110 offset:256
    s_waitcnt lgkmcnt(7)
    v_mfma_f32_16x16x32_bf16 v[144:147], v[56:59], v[88:91], v[144:147]
    ds_read_b128 v[32:35], v110 offset:512
    s_waitcnt lgkmcnt(7)
    v_mfma_f32_16x16x32_bf16 v[148:151], v[56:59], v[92:95], v[148:151]
    ds_read_b128 v[36:39], v110 offset:768
    s_waitcnt lgkmcnt(7)
    v_mfma_f32_16x16x32_bf16 v[152:155], v[56:59], v[96:99], v[152:155]
    ds_read_b128 v[40:43], v111 offset:1024
    s_waitcnt lgkmcnt(7)
    v_mfma_f32_16x16x32_bf16 v[156:159], v[56:59], v[100:103], v[156:159]
    ds_read_b128 v[44:47], v111 offset:1280
    s_waitcnt lgkmcnt(7)
    v_mfma_f32_16x16x32_bf16 v[188:191], v[60:63], v[100:103], v[188:191]
    ds_read_b128 v[48:51], v111 offset:1536
    v_mfma_f32_16x16x32_bf16 v[184:187], v[60:63], v[96:99], v[184:187]
    ds_read_b128 v[52:55], v111 offset:1792
    v_mfma_f32_16x16x32_bf16 v[180:183], v[60:63], v[92:95], v[180:183]
    ds_read_b128 v[12:15], v108 offset:6144
    v_mfma_f32_16x16x32_bf16 v[176:179], v[60:63], v[88:91], v[176:179]
    v_mfma_f32_16x16x32_bf16 v[172:175], v[60:63], v[84:87], v[172:175]
    v_mfma_f32_16x16x32_bf16 v[168:171], v[60:63], v[80:83], v[168:171]
    v_mfma_f32_16x16x32_bf16 v[164:167], v[60:63], v[76:79], v[164:167]
    v_mfma_f32_16x16x32_bf16 v[160:163], v[60:63], v[72:75], v[160:163]
    v_cvt_pk_bf16_f32 v20, v128, v132
    v_cvt_pk_bf16_f32 v21, v136, v140
    s_waitcnt lgkmcnt(8)
    v_mfma_f32_16x16x32_bf16 v[192:195], v[8:11], v[24:27], v[192:195]
    v_cvt_pk_bf16_f32 v22, v144, v148
    s_waitcnt lgkmcnt(7)
    v_mfma_f32_16x16x32_bf16 v[196:199], v[8:11], v[28:31], v[196:199]
    ds_read_b128 v[56:59], v109 offset:4096
    v_cvt_pk_bf16_f32 v23, v152, v156
    s_waitcnt lgkmcnt(7)
    v_mfma_f32_16x16x32_bf16 v[200:203], v[8:11], v[32:35], v[200:203]
    ds_read_b128 v[72:75], v110 offset:8192
    s_mov_b32 s47, 0
    s_waitcnt lgkmcnt(7)
    v_mfma_f32_16x16x32_bf16 v[204:207], v[8:11], v[36:39], v[204:207]
    ds_read_b128 v[76:79], v110 offset:8448
    buffer_store_dwordx4 v[20:23], v112, s[36:39], s47 offen nt
    s_waitcnt lgkmcnt(7)
    v_mfma_f32_16x16x32_bf16 v[208:211], v[8:11], v[40:43], v[208:211]
    ds_read_b128 v[80:83], v110 offset:8704
    v_cvt_pk_bf16_f32 v68, v129, v133
    s_waitcnt lgkmcnt(7)
    v_mfma_f32_16x16x32_bf16 v[212:215], v[8:11], v[44:47], v[212:215]
    ds_read_b128 v[84:87], v110 offset:8960
    v_cvt_pk_bf16_f32 v69, v137, v141
    s_waitcnt lgkmcnt(7)
    v_mfma_f32_16x16x32_bf16 v[216:219], v[8:11], v[48:51], v[216:219]
    ds_read_b128 v[88:91], v111 offset:9216
    v_cvt_pk_bf16_f32 v70, v145, v149
    s_waitcnt lgkmcnt(7)
    v_mfma_f32_16x16x32_bf16 v[220:223], v[8:11], v[52:55], v[220:223]
    ds_read_b128 v[92:95], v111 offset:9472
    v_cvt_pk_bf16_f32 v71, v153, v157
    s_waitcnt lgkmcnt(7)
    v_mfma_f32_16x16x32_bf16 v[252:255], v[12:15], v[52:55], v[252:255]
    ds_read_b128 v[96:99], v111 offset:9728
    s_mov_b32 s47, 7168
    v_mfma_f32_16x16x32_bf16 v[248:251], v[12:15], v[48:51], v[248:251]
    ds_read_b128 v[100:103], v111 offset:9984
    buffer_store_dwordx4 v[68:71], v112, s[36:39], s47 offen nt
    v_mfma_f32_16x16x32_bf16 v[244:247], v[12:15], v[44:47], v[244:247]
    ds_read_b128 v[60:63], v109 offset:6144
    v_cvt_pk_bf16_f32 v124, v130, v134
    v_cvt_pk_bf16_f32 v125, v138, v142
    v_mfma_f32_16x16x32_bf16 v[240:243], v[12:15], v[40:43], v[240:243]
    v_cvt_pk_bf16_f32 v126, v146, v150
    v_cvt_pk_bf16_f32 v127, v154, v158
    v_mfma_f32_16x16x32_bf16 v[236:239], v[12:15], v[36:39], v[236:239]
    s_mov_b32 s47, 14336
    buffer_store_dwordx4 v[124:127], v112, s[36:39], s47 offen nt
    v_mfma_f32_16x16x32_bf16 v[232:235], v[12:15], v[32:35], v[232:235]
    v_cvt_pk_bf16_f32 v0, v131, v135
    v_cvt_pk_bf16_f32 v1, v139, v143
    v_mfma_f32_16x16x32_bf16 v[228:231], v[12:15], v[28:31], v[228:231]
    v_cvt_pk_bf16_f32 v2, v147, v151
    v_cvt_pk_bf16_f32 v3, v155, v159
    v_mfma_f32_16x16x32_bf16 v[224:227], v[12:15], v[24:27], v[224:227]
    s_mov_b32 s47, 21504
    buffer_store_dwordx4 v[0:3], v112, s[36:39], s47 offen nt
    s_waitcnt lgkmcnt(8)
    v_mfma_f32_16x16x32_bf16 v[192:195], v[56:59], v[72:75], v[192:195]
    v_cvt_pk_bf16_f32 v4, v160, v164
    s_waitcnt lgkmcnt(7)
    v_mfma_f32_16x16x32_bf16 v[196:199], v[56:59], v[76:79], v[196:199]
    ds_read_b128 v[8:11], v116 offset:4096
    v_cvt_pk_bf16_f32 v5, v168, v172
    s_waitcnt lgkmcnt(7)
    v_mfma_f32_16x16x32_bf16 v[200:203], v[56:59], v[80:83], v[200:203]
    ds_read_b128 v[24:27], v118 offset:0
    v_cvt_pk_bf16_f32 v6, v176, v180
    s_waitcnt lgkmcnt(7)
    v_mfma_f32_16x16x32_bf16 v[204:207], v[56:59], v[84:87], v[204:207]
    ds_read_b128 v[28:31], v118 offset:256
    v_cvt_pk_bf16_f32 v7, v184, v188
    s_waitcnt lgkmcnt(7)
    v_mfma_f32_16x16x32_bf16 v[208:211], v[56:59], v[88:91], v[208:211]
    ds_read_b128 v[32:35], v118 offset:512
    s_mov_b32 s47, 114688
    s_waitcnt lgkmcnt(7)
    v_mfma_f32_16x16x32_bf16 v[212:215], v[56:59], v[92:95], v[212:215]
    ds_read_b128 v[36:39], v118 offset:768
    buffer_store_dwordx4 v[4:7], v112, s[36:39], s47 offen nt
    s_waitcnt lgkmcnt(7)
    v_mfma_f32_16x16x32_bf16 v[216:219], v[56:59], v[96:99], v[216:219]
    ds_read_b128 v[40:43], v119 offset:1024
    v_cvt_pk_bf16_f32 v16, v161, v165
    s_waitcnt lgkmcnt(7)
    v_mfma_f32_16x16x32_bf16 v[220:223], v[56:59], v[100:103], v[220:223]
    ds_read_b128 v[44:47], v119 offset:1280
    v_cvt_pk_bf16_f32 v17, v169, v173
    s_waitcnt lgkmcnt(7)
    v_mfma_f32_16x16x32_bf16 v[252:255], v[60:63], v[100:103], v[252:255]
    ds_read_b128 v[48:51], v119 offset:1536
    v_cvt_pk_bf16_f32 v18, v177, v181
    v_mfma_f32_16x16x32_bf16 v[248:251], v[60:63], v[96:99], v[248:251]
    ds_read_b128 v[52:55], v119 offset:1792
    v_cvt_pk_bf16_f32 v19, v185, v189
    v_mfma_f32_16x16x32_bf16 v[244:247], v[60:63], v[92:95], v[244:247]
    ds_read_b128 v[12:15], v116 offset:6144
    s_mov_b32 s47, 121856
    buffer_store_dwordx4 v[16:19], v112, s[36:39], s47 offen nt
    v_mfma_f32_16x16x32_bf16 v[240:243], v[60:63], v[88:91], v[240:243]
    v_cvt_pk_bf16_f32 v64, v162, v166
    v_cvt_pk_bf16_f32 v65, v170, v174
    v_mfma_f32_16x16x32_bf16 v[236:239], v[60:63], v[84:87], v[236:239]
    v_cvt_pk_bf16_f32 v66, v178, v182
    v_cvt_pk_bf16_f32 v67, v186, v190
    v_mfma_f32_16x16x32_bf16 v[232:235], v[60:63], v[80:83], v[232:235]
    s_mov_b32 s47, 129024
    buffer_store_dwordx4 v[64:67], v112, s[36:39], s47 offen nt
    v_mfma_f32_16x16x32_bf16 v[228:231], v[60:63], v[76:79], v[228:231]
    v_cvt_pk_bf16_f32 v20, v163, v167
    v_cvt_pk_bf16_f32 v21, v171, v175
    v_mfma_f32_16x16x32_bf16 v[224:227], v[60:63], v[72:75], v[224:227]
    v_cvt_pk_bf16_f32 v22, v179, v183
    v_cvt_pk_bf16_f32 v23, v187, v191
    s_waitcnt lgkmcnt(8)
    v_mfma_f32_16x16x32_bf16 v[192:195], v[8:11], v[24:27], v[192:195]
    ds_read_b128 v[56:59], v117 offset:4096
    ds_read_b128 v[72:75], v118 offset:8192
    s_mov_b32 s47, 136192
    s_waitcnt lgkmcnt(9)
    v_mfma_f32_16x16x32_bf16 v[196:199], v[8:11], v[28:31], v[196:199]
    ds_read_b128 v[76:79], v118 offset:8448
    ds_read_b128 v[80:83], v118 offset:8704
    buffer_store_dwordx4 v[20:23], v112, s[36:39], s47 offen nt
    s_waitcnt lgkmcnt(10)
    v_mfma_f32_16x16x32_bf16 v[200:203], v[8:11], v[32:35], v[200:203]
    ds_read_b128 v[84:87], v118 offset:8960
    ds_read_b128 v[88:91], v119 offset:9216
    s_waitcnt lgkmcnt(11)
    v_mfma_f32_16x16x32_bf16 v[204:207], v[8:11], v[36:39], v[204:207]
    ds_read_b128 v[92:95], v119 offset:9472
    ds_read_b128 v[96:99], v119 offset:9728
    s_waitcnt lgkmcnt(12)
    v_mfma_f32_16x16x32_bf16 v[208:211], v[8:11], v[40:43], v[208:211]
    ds_read_b128 v[100:103], v119 offset:9984
    ds_read_b128 v[60:63], v117 offset:6144
    s_waitcnt lgkmcnt(13)
    v_mfma_f32_16x16x32_bf16 v[212:215], v[8:11], v[44:47], v[212:215]
    s_waitcnt lgkmcnt(12)
    v_mfma_f32_16x16x32_bf16 v[216:219], v[8:11], v[48:51], v[216:219]
    s_waitcnt lgkmcnt(11)
    v_mfma_f32_16x16x32_bf16 v[220:223], v[8:11], v[52:55], v[220:223]
    s_waitcnt lgkmcnt(8)
    v_mfma_f32_16x16x32_bf16 v[192:195], v[56:59], v[72:75], v[192:195]
    s_waitcnt lgkmcnt(7)
    v_mfma_f32_16x16x32_bf16 v[196:199], v[56:59], v[76:79], v[196:199]
    s_waitcnt lgkmcnt(6)
    v_mfma_f32_16x16x32_bf16 v[200:203], v[56:59], v[80:83], v[200:203]
    s_waitcnt lgkmcnt(5)
    v_mfma_f32_16x16x32_bf16 v[204:207], v[56:59], v[84:87], v[204:207]
    s_waitcnt lgkmcnt(4)
    v_mfma_f32_16x16x32_bf16 v[208:211], v[56:59], v[88:91], v[208:211]
    s_waitcnt lgkmcnt(3)
    v_mfma_f32_16x16x32_bf16 v[212:215], v[56:59], v[92:95], v[212:215]
    s_waitcnt lgkmcnt(2)
    v_mfma_f32_16x16x32_bf16 v[216:219], v[56:59], v[96:99], v[216:219]
    s_waitcnt lgkmcnt(1)
    v_mfma_f32_16x16x32_bf16 v[220:223], v[56:59], v[100:103], v[220:223]
    v_mfma_f32_16x16x32_bf16 v[224:227], v[12:15], v[24:27], v[224:227]
    v_mfma_f32_16x16x32_bf16 v[228:231], v[12:15], v[28:31], v[228:231]
    v_mfma_f32_16x16x32_bf16 v[232:235], v[12:15], v[32:35], v[232:235]
    v_mfma_f32_16x16x32_bf16 v[236:239], v[12:15], v[36:39], v[236:239]
    v_mfma_f32_16x16x32_bf16 v[240:243], v[12:15], v[40:43], v[240:243]
    v_mfma_f32_16x16x32_bf16 v[244:247], v[12:15], v[44:47], v[244:247]
    v_mfma_f32_16x16x32_bf16 v[248:251], v[12:15], v[48:51], v[248:251]
    v_mfma_f32_16x16x32_bf16 v[252:255], v[12:15], v[52:55], v[252:255]
    v_cvt_pk_bf16_f32 v68, v192, v196
    v_cvt_pk_bf16_f32 v69, v200, v204
    s_waitcnt lgkmcnt(0)
    v_mfma_f32_16x16x32_bf16 v[224:227], v[60:63], v[72:75], v[224:227]
    v_cvt_pk_bf16_f32 v70, v208, v212
    v_cvt_pk_bf16_f32 v71, v216, v220
    v_mfma_f32_16x16x32_bf16 v[228:231], v[60:63], v[76:79], v[228:231]
    s_mov_b32 s47, 229376
    buffer_store_dwordx4 v[68:71], v112, s[36:39], s47 offen nt
    v_mfma_f32_16x16x32_bf16 v[232:235], v[60:63], v[80:83], v[232:235]
    v_cvt_pk_bf16_f32 v124, v193, v197
    v_cvt_pk_bf16_f32 v125, v201, v205
    v_mfma_f32_16x16x32_bf16 v[236:239], v[60:63], v[84:87], v[236:239]
    v_cvt_pk_bf16_f32 v126, v209, v213
    v_cvt_pk_bf16_f32 v127, v217, v221
    v_mfma_f32_16x16x32_bf16 v[240:243], v[60:63], v[88:91], v[240:243]
    s_mov_b32 s47, 236544
    buffer_store_dwordx4 v[124:127], v112, s[36:39], s47 offen nt
    v_mfma_f32_16x16x32_bf16 v[244:247], v[60:63], v[92:95], v[244:247]
    v_cvt_pk_bf16_f32 v0, v194, v198
    v_cvt_pk_bf16_f32 v1, v202, v206
    v_mfma_f32_16x16x32_bf16 v[248:251], v[60:63], v[96:99], v[248:251]
    v_cvt_pk_bf16_f32 v2, v210, v214
    v_cvt_pk_bf16_f32 v3, v218, v222
    v_mfma_f32_16x16x32_bf16 v[252:255], v[60:63], v[100:103], v[252:255]
    s_mov_b32 s47, 243712
    buffer_store_dwordx4 v[0:3], v112, s[36:39], s47 offen nt
    v_cvt_pk_bf16_f32 v4, v195, v199
    v_cvt_pk_bf16_f32 v5, v203, v207
    v_cvt_pk_bf16_f32 v6, v211, v215
    v_cvt_pk_bf16_f32 v7, v219, v223
    s_mov_b32 s47, 250880
    buffer_store_dwordx4 v[4:7], v112, s[36:39], s47 offen nt
    s_nop 7
    v_cvt_pk_bf16_f32 v16, v224, v228
    v_cvt_pk_bf16_f32 v17, v232, v236
    v_cvt_pk_bf16_f32 v18, v240, v244
    v_cvt_pk_bf16_f32 v19, v248, v252
    s_mov_b32 s47, 344064
    buffer_store_dwordx4 v[16:19], v112, s[36:39], s47 offen nt
    v_cvt_pk_bf16_f32 v64, v225, v229
    v_cvt_pk_bf16_f32 v65, v233, v237
    v_cvt_pk_bf16_f32 v66, v241, v245
    v_cvt_pk_bf16_f32 v67, v249, v253
    s_mov_b32 s47, 351232
    buffer_store_dwordx4 v[64:67], v112, s[36:39], s47 offen nt
    v_cvt_pk_bf16_f32 v20, v226, v230
    v_cvt_pk_bf16_f32 v21, v234, v238
    v_cvt_pk_bf16_f32 v22, v242, v246
    v_cvt_pk_bf16_f32 v23, v250, v254
    s_mov_b32 s47, 358400
    buffer_store_dwordx4 v[20:23], v112, s[36:39], s47 offen nt
    v_cvt_pk_bf16_f32 v68, v227, v231
    v_cvt_pk_bf16_f32 v69, v235, v239
    v_cvt_pk_bf16_f32 v70, v243, v247
    v_cvt_pk_bf16_f32 v71, v251, v255
    s_mov_b32 s47, 365568
    buffer_store_dwordx4 v[68:71], v112, s[36:39], s47 offen nt
    s_endpgm
L_help:
    s_getpc_b64 s[56:57]
L_pc:
    s_sub_u32 s56, s56, L_pc-standalone__weight_only_int_omniquant__prompt_kernel
    s_subb_u32 s57, s57, 0
    s_mov_b32 s58, L_codeend-standalone__weight_only_int_omniquant__prompt_kernel
    s_mov_b32 s59, 0x00020000
    v_lshlrev_b32 v10, 7, v0
    buffer_load_dword v9, v10, s[56:59], 0 offen
    s_sub_u32 s63, s63, 28
    s_and_b32 s45, s54, 1
    s_lshl_b32 s45, s45, 2
    s_add_u32 s45, s45, s63
    s_lshl_b32 s47, s45, 8
    s_lshl_b32 s48, s66, 6
    s_add_u32 s47, s47, s48
    s_lshl_b32 s47, s47, 11
    v_lshlrev_b32 v5, 11, v2
    v_add_u32 v5, s47, v5
    s_lshr_b32 s47, s44, 2
    s_lshl_b32 s47, s47, 3
    s_add_u32 s47, s47, s45
    s_lshl_b32 s51, s47, 7
    s_and_b32 s45, s54, 1
    s_lshl_b32 s45, s45, 2
    s_lshr_b32 s48, s54, 1
    s_add_u32 s45, s45, s48
    s_lshl_b32 s47, s45, 8
    s_lshl_b32 s48, s63, 6
    s_add_u32 s47, s47, s48
    s_lshl_b32 s55, s47, 11
    v_lshlrev_b32 v11, 11, v2
    v_add_u32 v11, s55, v11
    s_add_u32 s49, s44, 2
    s_add_u32 s47, s49, s45
    s_add_u32 s67, s47, 7
    s_and_b32 s67, s67, 7
    s_and_b32 s47, s47, 7
    s_or_b32 s47, s47, 8
    s_cmp_ge_u32 s49, 9
    s_cselect_b32 s67, s47, s67
    s_lshl_b32 s72, s67, 7
    s_add_u32 s49, s44, 10
    s_add_u32 s47, s49, s45
    s_add_u32 s67, s47, 7
    s_and_b32 s67, s67, 7
    s_and_b32 s47, s47, 7
    s_or_b32 s47, s47, 8
    s_cmp_ge_u32 s49, 9
    s_cselect_b32 s67, s47, s67
    s_lshl_b32 s73, s67, 7
    s_cmp_ge_u32 s44, 6
    s_cselect_b32 s73, 0x40000000, s73
    s_waitcnt lgkmcnt(0)
    s_mov_b32 s16, s4
    s_mov_b32 s17, s5
    s_mov_b32 s18, 4194304
    s_mov_b32 s19, 0x00020000
    buffer_load_dword v15, v5, s[16:19], s51 offen
    s_barrier
    buffer_load_dword v14, v11, s[16:19], s72 offen
    s_barrier
    buffer_load_dword v13, v11, s[16:19], s73 offen
L_end:
    s_endpgm
L_codeend:
.section .rodata,"a"
.p2align 6
.amdhsa_kernel standalone__weight_only_int_omniquant__prompt_kernel
  .amdhsa_next_free_vgpr 256
  .amdhsa_next_free_sgpr 102
  .amdhsa_accum_offset 256
  .amdhsa_group_segment_fixed_size 0
  .amdhsa_kernarg_size 64
  .amdhsa_user_sgpr_count 2
  .amdhsa_user_sgpr_kernarg_segment_ptr 1
  .amdhsa_system_sgpr_workgroup_id_x 1
  .amdhsa_float_denorm_mode_32 3
.end_amdhsa_kernel
```
